```python
import torch

def _softmax(x, axis=-1):
    return torch.softmax(x, dim=axis)
def _gelu(x):
    return torch.nn.functional.gelu(x, approximate="tanh")
def _silu(x):
    return torch.nn.functional.silu(x)
def _sigmoid(x):
    return torch.sigmoid(x)
def _layernorm(x, axis=-1, eps=1e-5):
    m = x.mean(dim=axis, keepdim=True)
    v = x.var(dim=axis, keepdim=True, unbiased=False)
    return (x - m) / torch.sqrt(v + eps)
def _scatter_add(tgt, idx, src, axis=0):
    return tgt.clone().index_add_(axis, idx, src)
def _segment_sum(src, seg, n):
    out = torch.zeros((n,) + src.shape[1:], dtype=src.dtype)
    return out.index_add_(0, seg, src)
def _pad(x, pw):
    flat = tuple(v for pair in reversed(pw) for v in pair)
    return torch.nn.functional.pad(x, flat)

kernel_name = 'concat_heads__gqa_block_cached__gqa_block_cached__decode'

def setup_inputs():

    _w = (lambda a: (lambda t: t.to(torch.bfloat16) if t.is_floating_point() else t)(torch.as_tensor(a)))
    def _A_setup():
        B, Sq, D = 1, 1, 576
        Hq, Hkv, Sk, Dh = 32, 16, 8192, 128
        assert Hq % Hkv == 0, (Hq, Hkv)
        return {
            "x": _w((lambda *s: torch.randn(*s, dtype=torch.bfloat16) * 0.8)(B, Sq, D)),
            "k_cache": _w((lambda *s: torch.randn(*s, dtype=torch.bfloat16) * 0.8)(B, Hkv, Sk, Dh)),
            "v_cache": _w((lambda *s: torch.randn(*s, dtype=torch.bfloat16) * 0.05)(B, Hkv, Sk, Dh)),
            "wq": _w((lambda *s: torch.randn(*s, dtype=torch.bfloat16) * 0.8)(D, Hq * Dh) * (D ** -0.5)),
            "wo": _w((lambda *s: torch.randn(*s, dtype=torch.bfloat16) * 0.05)(Hq * Dh, D) * ((Hq * Dh) ** -0.5)),
        }
    _A_in = _A_setup()

    def _B_setup():
        B, Sq, D = 1, 1, 576
        Hq, Hkv, Sk, Dh = 32, 16, 8192, 128
        assert Hq % Hkv == 0, (Hq, Hkv)
        return {
            "x": _w((lambda *s: torch.randn(*s, dtype=torch.bfloat16) * 0.8)(B, Sq, D)),
            "k_cache": _w((lambda *s: torch.randn(*s, dtype=torch.bfloat16) * 0.8)(B, Hkv, Sk, Dh)),
            "v_cache": _w((lambda *s: torch.randn(*s, dtype=torch.bfloat16) * 0.05)(B, Hkv, Sk, Dh)),
            "wq": _w((lambda *s: torch.randn(*s, dtype=torch.bfloat16) * 0.8)(D, Hq * Dh) * (D ** -0.5)),
            "wo": _w((lambda *s: torch.randn(*s, dtype=torch.bfloat16) * 0.05)(Hq * Dh, D) * ((Hq * Dh) ** -0.5)),
        }
    _B_in = _B_setup()

    return {
        "A_x": _A_in["x"],
        "A_k_cache": _A_in["k_cache"],
        "A_v_cache": _A_in["v_cache"],
        "A_wq": _A_in["wq"],
        "A_wo": _A_in["wo"],
        "B_x": _B_in["x"],
        "B_k_cache": _B_in["k_cache"],
        "B_v_cache": _B_in["v_cache"],
        "B_wq": _B_in["wq"],
        "B_wo": _B_in["wo"],
    }

def reference(A_x, A_k_cache, A_v_cache, A_wq, A_wo, B_x, B_k_cache, B_v_cache, B_wq, B_wo):
    def _A_ref(x, k_cache, v_cache, wq, wo):
        B, Sq, D = x.shape
        Hq, Dh = 32, 128
        Hkv = k_cache.shape[1]
        rep = Hq // Hkv
        q = (lambda x, *d: x.permute(*d))((x @ wq).reshape(B, Sq, Hq, Dh), 0, 2, 1, 3)
        k = (lambda x, n, axis: torch.repeat_interleave(x, n, dim=axis))(k_cache, rep, axis=1)
        v = (lambda x, n, axis: torch.repeat_interleave(x, n, dim=axis))(v_cache, rep, axis=1)
        scores = torch.einsum("bhqd,bhkd->bhqk", q, k) * (Dh ** -0.5)
        p = _softmax(scores, axis=-1)
        o = torch.einsum("bhqk,bhkd->bhqd", p, v)
        return (lambda x, *d: x.permute(*d))(o, 0, 2, 1, 3).reshape(B, Sq, Hq * Dh) @ wo

    def _B_ref(x, k_cache, v_cache, wq, wo):
        B, Sq, D = x.shape
        Hq, Dh = 32, 128
        Hkv = k_cache.shape[1]
        rep = Hq // Hkv
        q = (lambda x, *d: x.permute(*d))((x @ wq).reshape(B, Sq, Hq, Dh), 0, 2, 1, 3)
        k = (lambda x, n, axis: torch.repeat_interleave(x, n, dim=axis))(k_cache, rep, axis=1)
        v = (lambda x, n, axis: torch.repeat_interleave(x, n, dim=axis))(v_cache, rep, axis=1)
        scores = torch.einsum("bhqd,bhkd->bhqk", q, k) * (Dh ** -0.5)
        p = _softmax(scores, axis=-1)
        o = torch.einsum("bhqk,bhkd->bhqd", p, v)
        return (lambda x, *d: x.permute(*d))(o, 0, 2, 1, 3).reshape(B, Sq, Hq * Dh) @ wo

    a = _A_ref(A_x, A_k_cache, A_v_cache, A_wq, A_wo)
    b = _B_ref(B_x, B_k_cache, B_v_cache, B_wq, B_wo)
    return torch.concatenate([a, b], axis=-1)
```

```asm
; @launch grid=(256,1,1) block=(512,1,1) lds=17536
.amdgcn_target "amdgcn-amd-amdhsa--gfx950"
.text
.globl concat_heads__gqa_block_cached__gqa_block_cached__decode_kernel
.p2align 8
.type concat_heads__gqa_block_cached__gqa_block_cached__decode_kernel,@function
concat_heads__gqa_block_cached__gqa_block_cached__decode_kernel:
    s_cmpk_ge_u32 s2, 256
    s_cbranch_scc1 L_end
    s_load_dwordx16 s[4:19], s[0:1], 0
    s_load_dwordx8 s[20:27], s[0:1], 64
    s_load_dwordx2 s[28:29], s[0:1], 96
    v_bfe_u32 v73, v0, 4, 2
    s_movk_i32 s3, 0x1cc
    v_and_or_b32 v2, v0, s3, v73
    v_lshlrev_b32 v2, 6, v2
    v_and_b32 v74, 3, v0
    v_lshl_or_b32 v2, v74, 4, v2
    s_and_b32 s33, s2, 15
    s_lshr_b32 s31, s2, 5
    s_lshl3_add_u32 s60, s33, s31
    s_lshl_b32 s60, s60, 18
    s_mov_b32 s39, 0x20000
    s_lshl_b32 s38, s39, 1
    s_bitcmp1_b32 s2, 4
    s_waitcnt lgkmcnt(0)
    s_cselect_b64 s[6:7], s[16:17], s[6:7]
    s_add_u32 s36, s6, s60
    s_addc_u32 s37, s7, 0
    buffer_load_dwordx4 v[112:115], v2, s[36:39], 0 offen offset:0 nt
    buffer_load_dwordx4 v[116:119], v2, s[36:39], 0 offen offset:1024 nt
    buffer_load_dwordx4 v[120:123], v2, s[36:39], 0 offen offset:2048 nt
    v_lshrrev_b32 v72, 6, v0
    v_and_b32 v1, 63, v0
    v_readfirstlane_b32 s30, v72
    s_and_b32 s34, s2, 31
    v_and_b32 v74, 8, v1
    v_lshrrev_b32 v74, 1, v74
    v_or_b32 v75, v73, v74
    v_mul_u32_u24 v76, 48, v72
    v_mad_u32_u24 v76, v75, 6, v76
    v_lshlrev_b32 v5, 1, v76
    v_and_b32 v77, 7, v1
    v_lshlrev_b32 v77, 4, v77
    v_lshl_or_b32 v4, v76, 13, v77
    s_lshr_b32 s3, s2, 7
    s_mul_i32 s32, s3, 0x240000
    s_mul_i32 s3, s3, 576
    s_lshl_b32 s69, s33, 9
    s_add_u32 s32, s32, s69
    s_and_b32 s69, s31, 3
    s_lshl_b32 s69, s69, 7
    s_add_u32 s32, s32, s69
    s_mov_b32 s50, 576
    s_mov_b32 s51, 0x20000
    s_mov_b32 s46, 2351232
    s_mov_b32 s47, 0x20000
    s_bitcmp1_b32 s2, 4
    s_cselect_b64 s[4:5], s[14:15], s[4:5]
    s_cselect_b64 s[10:11], s[20:21], s[10:11]
    s_cselect_b64 s[8:9], s[18:19], s[8:9]
    s_cselect_b64 s[12:13], s[22:23], s[12:13]
    s_cselect_b32 s61, 0x100, 0
    s_add_u32 s48, s4, s3
    s_addc_u32 s49, s5, 0
    s_add_u32 s44, s10, s32
    s_addc_u32 s45, s11, 0
    buffer_load_dwordx3 v[10:12], v5, s[48:51], 0 offen
    buffer_load_dwordx4 v[88:91], v4, s[44:47], 0 offen nt
    s_mov_b32 s18, 0x2000
    buffer_load_dwordx4 v[92:95], v4, s[44:47], s18 offen nt
    s_mov_b32 s68, 0x8000
    s_mov_b32 s35, 0
    s_lshl_b32 s3, s30, 12
    s_add_u32 s60, s60, s3
    s_sub_u32 s42, 0x40000, s3
    s_add_u32 s40, s8, s60
    s_addc_u32 s41, s9, 0
    s_mov_b32 s43, 0x20000
    s_load_dword s60, s[28:29], s61
    s_mul_i32 s3, s33, 294912
    s_mul_i32 s32, s30, 36864
    s_add_u32 s3, s3, s32
    s_add_u32 s52, s12, s3
    s_addc_u32 s53, s13, 0
    s_mov_b32 s54, 36864
    s_mov_b32 s55, 0x20000
    s_mov_b32 s56, s28
    s_mov_b32 s57, s29
    s_mov_b32 s58, 0x200000
    s_mov_b32 s59, 0x20000
    v_lshlrev_b32 v3, 4, v1
    s_mov_b32 s70, 0x0f0f0f0f
    s_mov_b32 s71, 0x0f0f0f0f
    v_mov_b32 v84, 0xffff
    v_mov_b32 v85, 0
    v_lshlrev_b64 v[84:85], v3, v[84:85]
    s_mov_b32 s72, 0x01000100
    s_mov_b32 s73, 0x03020302
    v_cndmask_b32_e64 v6, 0, v84, s[70:71]
    v_cndmask_b32_e64 v7, 0, v85, s[70:71]
    v_cndmask_b32_e64 v8, v84, 0, s[70:71]
    v_cndmask_b32_e64 v9, v85, 0, s[70:71]
    s_lshl_b32 s75, s34, 3
    s_add_u32 s75, s75, s31
    s_lshl_b32 s75, s75, 8
    s_add_u32 s75, s75, 1572864
    s_mov_b32 s62, 0x07060501
    s_mov_b32 s63, 0x07060502
    s_mov_b32 s98, 0x07060503
    s_mov_b32 s69, 65536
    v_mov_b32 v19, v75
    v_mov_b32 v20, v77
    v_mov_b32 v14, v73
    s_getreg_b32 s21, hwreg(HW_REG_XCC_ID, 0, 4)
    s_waitcnt vmcnt(3)
    buffer_load_dwordx4 v[124:127], v2, s[36:39], 0 offen offset:3072 nt
    s_waitcnt vmcnt(2)
    s_add_u32 s18, s18, 0x2000
    buffer_load_dwordx4 v[96:99], v4, s[44:47], s18 offen nt
    v_perm_b32 v72, v10, v10, s72
    v_and_b32 v32, v72, v6
    v_and_b32 v33, v72, v7
    v_and_b32 v34, v72, v8
    v_and_b32 v35, v72, v9
    s_nop 1
    v_mfma_f32_16x16x32_bf16 v[44:47], v[32:35], v[88:91], 0
    s_waitcnt vmcnt(2)
    s_add_u32 s35, s35, s68
    buffer_load_dwordx4 v[128:131], v2, s[36:39], s35 offen offset:0 nt
    v_perm_b32 v73, v10, v10, s73
    v_and_b32 v36, v73, v6
    v_and_b32 v37, v73, v7
    v_and_b32 v38, v73, v8
    v_and_b32 v39, v73, v9
    s_nop 1
    v_mfma_f32_16x16x32_bf16 v[44:47], v[36:39], v[92:95], v[44:47]
    s_waitcnt vmcnt(2)
    s_add_u32 s18, s18, 0x2000
    buffer_load_dwordx4 v[100:103], v4, s[44:47], s18 offen nt
    s_waitcnt vmcnt(2)
    buffer_load_dwordx4 v[132:135], v2, s[36:39], s35 offen offset:1024 nt
    v_perm_b32 v72, v11, v11, s72
    v_and_b32 v32, v72, v6
    v_and_b32 v33, v72, v7
    v_and_b32 v34, v72, v8
    v_and_b32 v35, v72, v9
    s_nop 1
    v_mfma_f32_16x16x32_bf16 v[44:47], v[32:35], v[96:99], v[44:47]
    s_waitcnt vmcnt(2)
    s_add_u32 s18, s18, 0x2000
    buffer_load_dwordx4 v[104:107], v4, s[44:47], s18 offen nt
    s_waitcnt vmcnt(2)
    buffer_load_dwordx4 v[136:139], v2, s[36:39], s35 offen offset:2048 nt
    v_perm_b32 v73, v11, v11, s73
    v_and_b32 v36, v73, v6
    v_and_b32 v37, v73, v7
    v_and_b32 v38, v73, v8
    v_and_b32 v39, v73, v9
    s_nop 1
    v_mfma_f32_16x16x32_bf16 v[44:47], v[36:39], v[100:103], v[44:47]
    s_waitcnt vmcnt(2)
    s_add_u32 s18, s18, 0x2000
    buffer_load_dwordx4 v[108:111], v4, s[44:47], s18 offen nt
    s_waitcnt vmcnt(2)
    buffer_load_dwordx4 v[140:143], v2, s[36:39], s35 offen offset:3072 nt
    v_perm_b32 v72, v12, v12, s72
    v_and_b32 v32, v72, v6
    v_and_b32 v33, v72, v7
    v_and_b32 v34, v72, v8
    v_and_b32 v35, v72, v9
    s_nop 1
    v_mfma_f32_16x16x32_bf16 v[44:47], v[32:35], v[104:107], v[44:47]
    s_waitcnt vmcnt(2)
    s_add_u32 s35, s35, s68
    buffer_load_dwordx4 v[144:147], v2, s[36:39], s35 offen offset:0 nt
    s_waitcnt vmcnt(2)
    buffer_load_dwordx4 v[148:151], v2, s[36:39], s35 offen offset:1024 nt
    v_perm_b32 v73, v12, v12, s73
    v_and_b32 v36, v73, v6
    v_and_b32 v37, v73, v7
    v_and_b32 v38, v73, v8
    v_and_b32 v39, v73, v9
    s_nop 1
    v_mfma_f32_16x16x32_bf16 v[44:47], v[36:39], v[108:111], v[44:47]
    s_nop 7
    v_permlane32_swap_b32 v44, v46
    v_permlane32_swap_b32 v45, v47
    v_lshlrev_b32 v74, 1, v20
    v_and_b32 v75, 1, v14
    v_lshl_or_b32 v74, v75, 4, v74
    v_lshrrev_b32 v75, 1, v14
    v_lshl_or_b32 v74, v75, 3, v74
    s_lshl_b32 s3, s30, 8
    v_add_f32_dpp v44, v46, v44 row_ror:8 row_mask:0xf bank_mask:0xf
    v_add_f32_dpp v45, v47, v45 row_ror:8 row_mask:0xf bank_mask:0xf
    v_add_u32 v74, s3, v74
    s_mov_b32 exec_lo, 0x00ff00ff
    s_mov_b32 exec_hi, 0x00ff00ff
    ds_write_b64 v74, v[44:45] offset:0
    s_mov_b64 exec, -1
    s_waitcnt lgkmcnt(0)
    s_mul_i32 s60, s60, 1664525
    s_add_u32 s60, s60, 1013904223
    s_barrier
    s_cmp_eq_u32 s30, 0
    s_cselect_b64 vcc, -1, 0
    s_cbranch_scc0 ROLE_1
    s_mov_b64 exec, 0xffff
    ds_read_b128 v[88:91], v3 offset:0
    ds_read_b128 v[92:95], v3 offset:256
    ds_read_b128 v[96:99], v3 offset:512
    ds_read_b128 v[100:103], v3 offset:768
    ds_read_b128 v[104:107], v3 offset:1024
    ds_read_b128 v[108:111], v3 offset:1280
    s_waitcnt lgkmcnt(4)
    v_pk_add_f32 v[88:89], v[88:89], v[92:93]
    v_pk_add_f32 v[90:91], v[90:91], v[94:95]
    s_waitcnt lgkmcnt(2)
    v_pk_add_f32 v[96:97], v[96:97], v[100:101]
    v_pk_add_f32 v[98:99], v[98:99], v[102:103]
    s_waitcnt lgkmcnt(0)
    v_pk_add_f32 v[104:105], v[104:105], v[108:109]
    v_pk_add_f32 v[106:107], v[106:107], v[110:111]
    v_pk_add_f32 v[88:89], v[88:89], v[96:97]
    v_pk_add_f32 v[90:91], v[90:91], v[98:99]
    v_pk_add_f32 v[88:89], v[88:89], v[104:105]
    v_pk_add_f32 v[90:91], v[90:91], v[106:107]
    v_perm_b32 v88, v88, v91, s62
    v_perm_b32 v89, v89, v91, s63
    v_perm_b32 v90, v90, v91, s98
    v_mov_b32 v91, s60
    v_xor_b32 v91, s21, v91
    buffer_store_dwordx4 v[88:91], v3, s[56:59], s75 offen sc1
    s_mov_b64 exec, -1
ROLE_1:
    s_waitcnt vmcnt(3)
    s_cbranch_vccnz RW_2
    s_waitcnt vmcnt(2)
RW_2:
    buffer_load_dwordx4 v[152:155], v2, s[36:39], s35 offen offset:2048 nt
    s_mov_b32 s99, 0x0c04000c
    s_mov_b32 s100, 0x04020100
    s_mov_b32 s64, s24
    s_mov_b32 s65, s25
    s_mov_b32 s66, 2304
    s_mov_b32 s67, 0x20000
    s_mov_b32 s74, 0x3e0293ee
    s_lshl_b32 s76, s34, 11
    s_add_u32 s78, s76, 131072
    s_lshl_b32 s76, s34, 11
    s_add_u32 s76, s76, 1572864
    s_add_u32 s23, s76, 4096
    s_lshl_b32 s3, s31, 3
    s_add_u32 s3, s3, s30
    s_lshl_b32 s3, s3, 4
    s_add_u32 s77, s78, s3
    s_lshl_b32 s3, s34, 13
    s_add_u32 s3, s3, 196608
    s_lshl_b32 s32, s30, 10
    s_add_u32 s80, s3, s32
    s_lshl_b32 s32, s30, 10
    s_add_u32 s79, s3, s32
    s_lshl_b32 s32, s31, 7
    s_add_u32 s79, s79, s32
    s_lshl_b32 s101, s31, 4
    s_add_u32 s101, s101, s33
    s_lshr_b32 s3, s34, 4
    s_mul_i32 s3, s3, 72
    s_add_u32 s32, s3, s101
    s_lshl_b32 s83, s32, 4
    s_lshl_b32 s82, s32, 10
    s_add_u32 s82, s82, 458752
    s_lshl_b32 s32, s31, 3
    s_add_u32 s3, s3, s32
    s_lshl_b32 s3, s3, 10
    s_lshl_b32 s32, s33, 5
    s_add_u32 s3, s3, s32
    s_add_u32 s81, s3, 458752
    s_cmp_ge_u32 s101, 8
    s_cselect_b32 s25, -1, 0
    s_cmp_lt_u32 s101, 64
    s_cselect_b32 s24, -1, 0
    s_mov_b32 s84, 0x01010101
    s_mov_b32 s85, 0x01010101
    s_mov_b32 s86, 0x00ff00ff
    s_mov_b32 s32, 0x100000
    s_cmp_eq_u32 s30, s31
    s_cselect_b32 s87, s86, 0
    s_cselect_b32 s32, 0x80, s32
    s_mov_b32 s88, 0x00030003
    s_mov_b32 s89, 0x00030003
    s_lshl_b32 s3, s31, 3
    s_lshl_b64 s[90:91], 0xff, s3
    v_lshl_or_b32 v18, v20, 3, 0
    v_lshl_or_b32 v18, v19, 4, v18
    v_and_b32 v72, 1, v14
    v_lshrrev_b32 v73, 1, v14
    s_cmp_ge_u32 s30, s31
    s_cselect_b32 s3, 1, 0
    s_add_u32 s3, s3, s30
    s_lshl_b32 s3, s3, 8
    s_add_u32 s3, s3, 3328
    v_lshlrev_b32 v4, 1, v20
    v_lshl_or_b32 v4, v72, 4, v4
    v_lshlrev_b32 v74, 8, v73
    v_sub_u32 v4, v4, v74
    v_add_u32 v4, s3, v4
    v_and_b32 v13, 15, v1
    v_lshlrev_b32 v13, 4, v13
    v_xor_b32 v74, 1, v72
    v_lshl_or_b32 v13, v74, 11, v13
    s_lshl_b32 s3, s31, 8
    s_add_u32 s3, s3, 1536
    v_add_u32 v13, s3, v13
    v_and_b32 v21, 14, v1
    v_lshlrev_b32 v21, 9, v21
    v_and_b32 v74, 1, v1
    v_lshl_or_b32 v21, v74, 4, v21
    v_mul_u32_u24 v74, 8704, v72
    v_add_u32 v21, v21, v74
    v_lshl_or_b32 v21, v73, 3, v21
    s_cmp_lt_u32 s30, 6
    s_cselect_b64 exec, -1, 0
    s_lshl_b32 s3, s30, 10
    v_add_u32 v74, s3, v3
    v_mov_b32 v76, 0
    v_mov_b32 v77, 0
    v_mov_b32 v78, 0
    v_mov_b32 v79, 0
    ds_write_b128 v74, v[76:79] offset:1536
    s_mov_b64 exec, -1
    v_and_b32 v22, 1, v1
    v_lshl_add_u32 v22, v22, 2, v14
    v_lshlrev_b32 v22, 1, v22
    v_lshrrev_b32 v23, 2, v20
    s_lshr_b32 s3, s30, 2
    s_lshl_b32 s3, s3, 5
    v_add_u32 v16, s3, v23
    v_and_b32 v17, 0x38, v1
    v_lshlrev_b32 v17, 1, v17
    v_mul_u32_u24 v15, 65, v20
    v_add_u32 v15, v15, v17
    s_lshl_b32 s3, s30, 7
    v_add_u32 v15, s3, v15
    v_and_b32 v74, 15, v1
    v_lshlrev_b32 v14, 5, v74
    v_lshl_or_b32 v14, v72, 4, v14
    v_lshl_or_b32 v14, v73, 9, v14
    s_mul_i32 s3, s30, 1040
    v_add_u32 v14, s3, v14
    v_mul_u32_u24 v19, 4608, v19
    v_add_u32 v19, v19, v20
    s_cmp_lt_u32 s30, s31
    s_addc_u32 s3, s31, 0
    s_lshl_b32 s3, s3, 7
    v_add_u32 v19, s3, v19
    v_add_u32 v20, s32, v19
    v_and_b32 v5, 0xff, v2
    v_lshrrev_b32 v72, 1, v2
    v_and_b32 v72, 0x100, v72
    v_or_b32 v5, v5, v72
    s_waitcnt vmcnt(3)
    s_cbranch_vccnz RW_3
    s_waitcnt vmcnt(2)
RW_3:
    buffer_load_dwordx4 v[156:159], v2, s[36:39], s35 offen offset:3072 nt
    s_waitcnt vmcnt(3)
    s_cbranch_vccnz RW_4
    s_waitcnt vmcnt(2)
RW_4:
    s_add_u32 s35, s35, s68
    buffer_load_dwordx4 v[160:163], v2, s[36:39], s35 offen offset:0 nt
    s_waitcnt vmcnt(2)
    buffer_load_dwordx4 v[164:167], v2, s[36:39], s35 offen offset:1024 nt
    s_waitcnt vmcnt(2)
    buffer_load_dwordx4 v[168:171], v2, s[36:39], s35 offen offset:2048 nt
    s_waitcnt vmcnt(2)
    buffer_load_dwordx4 v[172:175], v2, s[36:39], s35 offen offset:3072 nt
    s_waitcnt vmcnt(2)
    s_add_u32 s35, s35, s68
    buffer_load_dwordx4 v[176:179], v2, s[36:39], s35 offen offset:0 nt
    s_waitcnt vmcnt(2)
    buffer_load_dwordx4 v[180:183], v2, s[36:39], s35 offen offset:1024 nt
    s_cmp_eq_u32 s30, 1
    s_cselect_b64 vcc, -1, 0
    s_cbranch_scc0 ROLE_5
    buffer_load_dwordx4 v[88:91], v3, s[56:59], s76 offen offset:0 sc1
    buffer_load_dwordx4 v[92:95], v3, s[56:59], s76 offen offset:1024 sc1
ROLE_5:
    s_waitcnt vmcnt(4)
    s_cbranch_vccnz RW_6
    s_waitcnt vmcnt(2)
RW_6:
    buffer_load_dwordx4 v[184:187], v2, s[36:39], s35 offen offset:2048 nt
    s_waitcnt vmcnt(4)
    s_cbranch_vccnz RW_7
    s_waitcnt vmcnt(2)
RW_7:
    buffer_load_dwordx4 v[188:191], v2, s[36:39], s35 offen offset:3072 nt
    s_waitcnt vmcnt(4)
    s_cbranch_vccnz RW_8
    s_waitcnt vmcnt(2)
RW_8:
    s_add_u32 s35, s35, s68
    buffer_load_dwordx4 v[192:195], v2, s[36:39], s35 offen offset:0 nt
    s_cmp_lg_u32 s30, 1
    s_cbranch_scc1 SKIP_9
    s_waitcnt vmcnt(3)
CHK_10:
    v_xor_b32 v76, s60, v91
    v_xor_b32 v77, s60, v95
    v_or_b32 v78, v76, v77
    v_cmp_lt_u32 vcc, 15, v78
    s_cbranch_vccz OK_11
    s_cmp_eq_u32 s69, 0
    s_cbranch_scc1 OK_11
    s_sub_u32 s69, s69, 1
    s_mov_b64 exec, vcc
    buffer_load_dwordx4 v[88:91], v3, s[56:59], s76 offen offset:0 sc1
    buffer_load_dwordx4 v[92:95], v3, s[56:59], s76 offen offset:1024 sc1
    s_mov_b64 exec, -1
    s_waitcnt vmcnt(0)
    s_branch CHK_10
OK_11:
    v_cmp_ne_u32 vcc, s21, v76
    v_cmp_ne_u32_e64 s[26:27], s21, v77
    s_or_b64 vcc, vcc, s[26:27]
    s_cselect_b32 s22, 0, 1
    v_mov_b32 v76, s22
    ds_write_b32 v3, v76 offset:7680
    v_perm_b32 v91, v89, v88, s99
    v_perm_b32 v95, v93, v92, s99
    v_perm_b32 v91, v90, v91, s100
    v_perm_b32 v95, v94, v95, s100
    v_pk_add_f32 v[88:89], v[88:89], v[92:93]
    v_pk_add_f32 v[90:91], v[90:91], v[94:95]
    v_lshlrev_b32 v74, 3, v1
    v_cvt_pk_bf16_f32 v72, v88, v89
    v_cvt_pk_bf16_f32 v73, v90, v91
    ds_write_b64 v74, v[72:73] offset:8192
    s_waitcnt lgkmcnt(0)
SKIP_9:
    s_barrier
    v_mov_b32 v73, 0
    ds_read_b32 v72, v73 offset:7680
    ds_read_b128 v[28:31], v5 offset:8192
    s_waitcnt lgkmcnt(0)
    v_readfirstlane_b32 s22, v72
    v_cndmask_b32_e64 v24, 0, v28, s[70:71]
    v_cndmask_b32_e64 v25, 0, v29, s[70:71]
    v_cndmask_b32_e64 v26, 0, v30, s[70:71]
    v_cndmask_b32_e64 v27, 0, v31, s[70:71]
    v_cndmask_b32_e64 v28, v28, 0, s[70:71]
    v_cndmask_b32_e64 v29, v29, 0, s[70:71]
    v_cndmask_b32_e64 v30, v30, 0, s[70:71]
    v_cndmask_b32_e64 v31, v31, 0, s[70:71]
    v_mfma_f32_16x16x32_bf16 v[44:47], v[112:115], v[24:27], 0
    s_nop 0
    v_mfma_f32_16x16x32_bf16 v[44:47], v[116:119], v[28:31], v[44:47]
    s_nop 7
    v_add_f32_dpp v52, v45, v44 quad_perm:[1,1,1,1] row_mask:0xf bank_mask:0xf
    v_add_f32_dpp v46, v47, v46 quad_perm:[0,1,3,3] row_mask:0xf bank_mask:0xf
    s_nop 1
    v_add_f32_dpp v52, v46, v52 quad_perm:[2,2,2,2] row_mask:0xf bank_mask:0xf
    s_waitcnt vmcnt(2)
    buffer_load_dwordx4 v[196:199], v2, s[36:39], s35 offen offset:1024 nt
    v_mfma_f32_16x16x32_bf16 v[48:51], v[120:123], v[24:27], 0
    v_mfma_f32_16x16x32_bf16 v[48:51], v[124:127], v[28:31], v[48:51]
    v_mfma_f32_16x16x32_bf16 v[44:47], v[128:131], v[24:27], 0
    v_mfma_f32_16x16x32_bf16 v[44:47], v[132:135], v[28:31], v[44:47]
    s_nop 5
    v_add_f32_dpp v53, v49, v48 quad_perm:[1,1,1,1] row_mask:0xf bank_mask:0xf
    v_add_f32_dpp v50, v51, v50 quad_perm:[0,1,3,3] row_mask:0xf bank_mask:0xf
    v_add_f32_dpp v54, v45, v44 quad_perm:[1,1,1,1] row_mask:0xf bank_mask:0xf
    v_add_f32_dpp v46, v47, v46 quad_perm:[0,1,3,3] row_mask:0xf bank_mask:0xf
    v_add_f32_dpp v53, v50, v53 quad_perm:[2,2,2,2] row_mask:0xf bank_mask:0xf
    s_nop 0
    v_add_f32_dpp v54, v46, v54 quad_perm:[2,2,2,2] row_mask:0xf bank_mask:0xf
    v_max_f32 v71, v52, v53
    v_max_f32 v71, v71, v54
    s_waitcnt vmcnt(2)
    buffer_load_dwordx4 v[200:203], v2, s[36:39], s35 offen offset:2048 nt
    v_mfma_f32_16x16x32_bf16 v[48:51], v[136:139], v[24:27], 0
    v_mfma_f32_16x16x32_bf16 v[48:51], v[140:143], v[28:31], v[48:51]
    v_mfma_f32_16x16x32_bf16 v[44:47], v[144:147], v[24:27], 0
    v_mfma_f32_16x16x32_bf16 v[44:47], v[148:151], v[28:31], v[44:47]
    s_nop 5
    v_add_f32_dpp v55, v49, v48 quad_perm:[1,1,1,1] row_mask:0xf bank_mask:0xf
    v_add_f32_dpp v50, v51, v50 quad_perm:[0,1,3,3] row_mask:0xf bank_mask:0xf
    v_add_f32_dpp v56, v45, v44 quad_perm:[1,1,1,1] row_mask:0xf bank_mask:0xf
    v_add_f32_dpp v46, v47, v46 quad_perm:[0,1,3,3] row_mask:0xf bank_mask:0xf
    v_add_f32_dpp v55, v50, v55 quad_perm:[2,2,2,2] row_mask:0xf bank_mask:0xf
    s_nop 0
    v_add_f32_dpp v56, v46, v56 quad_perm:[2,2,2,2] row_mask:0xf bank_mask:0xf
    v_max_f32 v71, v71, v55
    v_max_f32 v71, v71, v56
    s_waitcnt vmcnt(2)
    buffer_load_dwordx4 v[204:207], v2, s[36:39], s35 offen offset:3072 nt
    v_mfma_f32_16x16x32_bf16 v[48:51], v[152:155], v[24:27], 0
    v_mfma_f32_16x16x32_bf16 v[48:51], v[156:159], v[28:31], v[48:51]
    v_mfma_f32_16x16x32_bf16 v[44:47], v[160:163], v[24:27], 0
    v_mfma_f32_16x16x32_bf16 v[44:47], v[164:167], v[28:31], v[44:47]
    s_nop 5
    v_add_f32_dpp v57, v49, v48 quad_perm:[1,1,1,1] row_mask:0xf bank_mask:0xf
    v_add_f32_dpp v50, v51, v50 quad_perm:[0,1,3,3] row_mask:0xf bank_mask:0xf
    v_add_f32_dpp v58, v45, v44 quad_perm:[1,1,1,1] row_mask:0xf bank_mask:0xf
    v_add_f32_dpp v46, v47, v46 quad_perm:[0,1,3,3] row_mask:0xf bank_mask:0xf
    v_add_f32_dpp v57, v50, v57 quad_perm:[2,2,2,2] row_mask:0xf bank_mask:0xf
    s_nop 0
    v_add_f32_dpp v58, v46, v58 quad_perm:[2,2,2,2] row_mask:0xf bank_mask:0xf
    v_max_f32 v71, v71, v57
    v_max_f32 v71, v71, v58
    s_waitcnt vmcnt(2)
    s_add_u32 s35, s35, s68
    buffer_load_dwordx4 v[208:211], v2, s[36:39], s35 offen offset:0 nt
    v_mfma_f32_16x16x32_bf16 v[48:51], v[168:171], v[24:27], 0
    v_mfma_f32_16x16x32_bf16 v[48:51], v[172:175], v[28:31], v[48:51]
    v_mfma_f32_16x16x32_bf16 v[44:47], v[176:179], v[24:27], 0
    v_mfma_f32_16x16x32_bf16 v[44:47], v[180:183], v[28:31], v[44:47]
    s_nop 5
    v_add_f32_dpp v59, v49, v48 quad_perm:[1,1,1,1] row_mask:0xf bank_mask:0xf
    v_add_f32_dpp v50, v51, v50 quad_perm:[0,1,3,3] row_mask:0xf bank_mask:0xf
    v_add_f32_dpp v60, v45, v44 quad_perm:[1,1,1,1] row_mask:0xf bank_mask:0xf
    v_add_f32_dpp v46, v47, v46 quad_perm:[0,1,3,3] row_mask:0xf bank_mask:0xf
    v_add_f32_dpp v59, v50, v59 quad_perm:[2,2,2,2] row_mask:0xf bank_mask:0xf
    s_nop 0
    v_add_f32_dpp v60, v46, v60 quad_perm:[2,2,2,2] row_mask:0xf bank_mask:0xf
    v_max_f32 v71, v71, v59
    v_max_f32 v71, v71, v60
    s_waitcnt vmcnt(2)
    buffer_load_dwordx4 v[212:215], v2, s[36:39], s35 offen offset:1024 nt
    v_mfma_f32_16x16x32_bf16 v[48:51], v[184:187], v[24:27], 0
    v_mfma_f32_16x16x32_bf16 v[48:51], v[188:191], v[28:31], v[48:51]
    v_mfma_f32_16x16x32_bf16 v[44:47], v[192:195], v[24:27], 0
    v_mfma_f32_16x16x32_bf16 v[44:47], v[196:199], v[28:31], v[44:47]
    s_nop 5
    v_add_f32_dpp v61, v49, v48 quad_perm:[1,1,1,1] row_mask:0xf bank_mask:0xf
    v_add_f32_dpp v50, v51, v50 quad_perm:[0,1,3,3] row_mask:0xf bank_mask:0xf
    v_add_f32_dpp v62, v45, v44 quad_perm:[1,1,1,1] row_mask:0xf bank_mask:0xf
    v_add_f32_dpp v46, v47, v46 quad_perm:[0,1,3,3] row_mask:0xf bank_mask:0xf
    v_add_f32_dpp v61, v50, v61 quad_perm:[2,2,2,2] row_mask:0xf bank_mask:0xf
    s_nop 0
    v_add_f32_dpp v62, v46, v62 quad_perm:[2,2,2,2] row_mask:0xf bank_mask:0xf
    v_max_f32 v71, v71, v61
    v_max_f32 v71, v71, v62
    s_waitcnt vmcnt(2)
    buffer_load_dwordx4 v[216:219], v2, s[36:39], s35 offen offset:2048 nt
    v_mfma_f32_16x16x32_bf16 v[48:51], v[200:203], v[24:27], 0
    v_mfma_f32_16x16x32_bf16 v[48:51], v[204:207], v[28:31], v[48:51]
    s_nop 7
    v_add_f32_dpp v63, v49, v48 quad_perm:[1,1,1,1] row_mask:0xf bank_mask:0xf
    v_add_f32_dpp v50, v51, v50 quad_perm:[0,1,3,3] row_mask:0xf bank_mask:0xf
    s_nop 1
    v_add_f32_dpp v63, v50, v63 quad_perm:[2,2,2,2] row_mask:0xf bank_mask:0xf
    v_max_f32 v71, v71, v63
    s_waitcnt vmcnt(2)
    buffer_load_dwordx4 v[220:223], v2, s[36:39], s35 offen offset:3072 nt
    s_waitcnt vmcnt(2)
    s_add_u32 s35, s35, s68
    buffer_load_dwordx4 v[224:227], v2, s[36:39], s35 offen offset:0 nt
    v_mfma_f32_16x16x32_bf16 v[44:47], v[208:211], v[24:27], 0
    v_mfma_f32_16x16x32_bf16 v[44:47], v[212:215], v[28:31], v[44:47]
    s_nop 7
    v_add_f32_dpp v64, v45, v44 quad_perm:[1,1,1,1] row_mask:0xf bank_mask:0xf
    v_add_f32_dpp v46, v47, v46 quad_perm:[0,1,3,3] row_mask:0xf bank_mask:0xf
    s_nop 1
    v_add_f32_dpp v64, v46, v64 quad_perm:[2,2,2,2] row_mask:0xf bank_mask:0xf
    v_max_f32 v71, v71, v64
    s_waitcnt vmcnt(2)
    buffer_load_dwordx4 v[228:231], v2, s[36:39], s35 offen offset:1024 nt
    s_waitcnt vmcnt(2)
    buffer_load_dwordx4 v[232:235], v2, s[36:39], s35 offen offset:2048 nt
    v_mfma_f32_16x16x32_bf16 v[48:51], v[216:219], v[24:27], 0
    v_mfma_f32_16x16x32_bf16 v[48:51], v[220:223], v[28:31], v[48:51]
    s_nop 7
    v_add_f32_dpp v65, v49, v48 quad_perm:[1,1,1,1] row_mask:0xf bank_mask:0xf
    v_add_f32_dpp v50, v51, v50 quad_perm:[0,1,3,3] row_mask:0xf bank_mask:0xf
    s_nop 1
    v_add_f32_dpp v65, v50, v65 quad_perm:[2,2,2,2] row_mask:0xf bank_mask:0xf
    v_max_f32 v71, v71, v65
    s_waitcnt vmcnt(2)
    buffer_load_dwordx4 v[236:239], v2, s[36:39], s35 offen offset:3072 nt
    s_waitcnt vmcnt(2)
    s_mov_b32 s35, 0
    buffer_load_dwordx4 v[112:115], v3, s[40:43], s35 offen offset:0 nt
    v_mfma_f32_16x16x32_bf16 v[44:47], v[224:227], v[24:27], 0
    v_mfma_f32_16x16x32_bf16 v[44:47], v[228:231], v[28:31], v[44:47]
    s_nop 7
    v_add_f32_dpp v66, v45, v44 quad_perm:[1,1,1,1] row_mask:0xf bank_mask:0xf
    v_add_f32_dpp v46, v47, v46 quad_perm:[0,1,3,3] row_mask:0xf bank_mask:0xf
    s_nop 1
    v_add_f32_dpp v66, v46, v66 quad_perm:[2,2,2,2] row_mask:0xf bank_mask:0xf
    v_max_f32 v71, v71, v66
    s_waitcnt vmcnt(2)
    buffer_load_dwordx4 v[116:119], v3, s[40:43], s35 offen offset:1024 nt
    s_waitcnt vmcnt(2)
    buffer_load_dwordx4 v[120:123], v3, s[40:43], s35 offen offset:2048 nt
    v_mfma_f32_16x16x32_bf16 v[48:51], v[232:235], v[24:27], 0
    v_mfma_f32_16x16x32_bf16 v[48:51], v[236:239], v[28:31], v[48:51]
    s_nop 7
    v_add_f32_dpp v67, v49, v48 quad_perm:[1,1,1,1] row_mask:0xf bank_mask:0xf
    v_add_f32_dpp v50, v51, v50 quad_perm:[0,1,3,3] row_mask:0xf bank_mask:0xf
    s_nop 1
    v_add_f32_dpp v67, v50, v67 quad_perm:[2,2,2,2] row_mask:0xf bank_mask:0xf
    v_max_f32 v71, v71, v67
    s_nop 1
    v_mov_b32_dpp v68, v71 quad_perm:[0,0,0,0] row_mask:0xf bank_mask:0xf
    s_nop 1
    v_max_f32_dpp v68, v68, v68 row_half_mirror row_mask:0xf bank_mask:0xf
    v_mov_b32 v72, v68
    s_nop 1
    v_permlane16_swap_b32 v68, v72
    v_max_f32 v68, v68, v72
    v_mov_b32 v72, v68
    s_nop 1
    v_permlane32_swap_b32 v68, v72
    v_max_f32 v68, v68, v72
    v_mul_f32 v68, s74, v68
    v_fma_f32 v52, v52, s74, -v68
    v_fma_f32 v53, v53, s74, -v68
    v_fma_f32 v54, v54, s74, -v68
    v_fma_f32 v55, v55, s74, -v68
    v_exp_f32_dpp v72, v52 quad_perm:[0,0,0,0] row_mask:0xf bank_mask:0xf
    v_exp_f32_dpp v73, v53 quad_perm:[0,0,0,0] row_mask:0xf bank_mask:0xf
    v_exp_f32_dpp v74, v54 quad_perm:[0,0,0,0] row_mask:0xf bank_mask:0xf
    v_exp_f32_dpp v75, v55 quad_perm:[0,0,0,0] row_mask:0xf bank_mask:0xf
    v_cvt_pk_bf16_f32 v52, v72, v72
    v_mov_b32 v69, v72
    v_cvt_pk_bf16_f32 v53, v73, v73
    v_add_f32 v69, v69, v73
    v_cvt_pk_bf16_f32 v54, v74, v74
    v_add_f32 v69, v69, v74
    v_cvt_pk_bf16_f32 v55, v75, v75
    v_add_f32 v69, v69, v75
    s_waitcnt vmcnt(2)
    buffer_load_dwordx4 v[124:127], v3, s[40:43], s35 offen offset:3072 nt
    v_fma_f32 v56, v56, s74, -v68
    v_fma_f32 v57, v57, s74, -v68
    v_fma_f32 v58, v58, s74, -v68
    v_fma_f32 v59, v59, s74, -v68
    v_fma_f32 v60, v60, s74, -v68
    v_fma_f32 v61, v61, s74, -v68
    v_exp_f32_dpp v72, v56 quad_perm:[0,0,0,0] row_mask:0xf bank_mask:0xf
    v_exp_f32_dpp v73, v57 quad_perm:[0,0,0,0] row_mask:0xf bank_mask:0xf
    v_exp_f32_dpp v74, v58 quad_perm:[0,0,0,0] row_mask:0xf bank_mask:0xf
    v_exp_f32_dpp v75, v59 quad_perm:[0,0,0,0] row_mask:0xf bank_mask:0xf
    v_exp_f32_dpp v76, v60 quad_perm:[0,0,0,0] row_mask:0xf bank_mask:0xf
    v_exp_f32_dpp v77, v61 quad_perm:[0,0,0,0] row_mask:0xf bank_mask:0xf
    v_cvt_pk_bf16_f32 v56, v72, v72
    v_add_f32 v69, v69, v72
    v_cvt_pk_bf16_f32 v57, v73, v73
    v_add_f32 v69, v69, v73
    v_cvt_pk_bf16_f32 v58, v74, v74
    v_add_f32 v69, v69, v74
    v_cvt_pk_bf16_f32 v59, v75, v75
    v_add_f32 v69, v69, v75
    v_cvt_pk_bf16_f32 v60, v76, v76
    v_add_f32 v69, v69, v76
    v_cvt_pk_bf16_f32 v61, v77, v77
    v_add_f32 v69, v69, v77
    s_waitcnt vmcnt(2)
    s_add_u32 s35, s35, s68
    buffer_load_dwordx4 v[128:131], v3, s[40:43], s35 offen offset:0 nt
    v_fma_f32 v62, v62, s74, -v68
    v_fma_f32 v63, v63, s74, -v68
    v_fma_f32 v64, v64, s74, -v68
    v_fma_f32 v65, v65, s74, -v68
    v_fma_f32 v66, v66, s74, -v68
    v_fma_f32 v67, v67, s74, -v68
    v_exp_f32_dpp v72, v62 quad_perm:[0,0,0,0] row_mask:0xf bank_mask:0xf
    v_exp_f32_dpp v73, v63 quad_perm:[0,0,0,0] row_mask:0xf bank_mask:0xf
    v_exp_f32_dpp v74, v64 quad_perm:[0,0,0,0] row_mask:0xf bank_mask:0xf
    v_exp_f32_dpp v75, v65 quad_perm:[0,0,0,0] row_mask:0xf bank_mask:0xf
    v_exp_f32_dpp v76, v66 quad_perm:[0,0,0,0] row_mask:0xf bank_mask:0xf
    v_exp_f32_dpp v77, v67 quad_perm:[0,0,0,0] row_mask:0xf bank_mask:0xf
    v_cvt_pk_bf16_f32 v62, v72, v72
    v_add_f32 v69, v69, v72
    v_cvt_pk_bf16_f32 v63, v73, v73
    v_add_f32 v69, v69, v73
    v_cvt_pk_bf16_f32 v64, v74, v74
    v_add_f32 v69, v69, v74
    v_cvt_pk_bf16_f32 v65, v75, v75
    v_add_f32 v69, v69, v75
    v_cvt_pk_bf16_f32 v66, v76, v76
    v_add_f32 v69, v69, v76
    v_cvt_pk_bf16_f32 v67, v77, v77
    v_add_f32 v69, v69, v77
    s_nop 1
    v_add_f32_dpp v69, v69, v69 row_half_mirror row_mask:0xf bank_mask:0xf
    v_mov_b32 v72, v69
    s_nop 1
    v_permlane16_swap_b32 v69, v72
    v_add_f32 v69, v69, v72
    v_mov_b32 v72, v69
    s_nop 1
    v_permlane32_swap_b32 v69, v72
    v_add_f32 v69, v69, v72
    v_mov_b32 v70, s60
    v_lshlrev_b32 v72, 7, v1
    s_mov_b64 exec, 0x101
    s_cmp_eq_u32 s22, 0
    s_cbranch_scc1 FAR_12
    buffer_store_dwordx3 v[68:70], v72, s[56:59], s77 offen
    s_branch STD_13
FAR_12:
    buffer_store_dwordx3 v[68:70], v72, s[56:59], s77 offen sc1
STD_13:
    s_mov_b64 exec, -1
    s_waitcnt vmcnt(3)
    buffer_load_dwordx4 v[132:135], v3, s[40:43], s35 offen offset:1024 nt
    v_and_b32 v32, v52, v6
    v_and_b32 v33, v52, v7
    v_and_b32_dpp v34, v52, v8 row_shr:4 row_mask:0xf bank_mask:0xf bound_ctrl:0
    v_and_b32_dpp v35, v52, v9 row_shr:4 row_mask:0xf bank_mask:0xf bound_ctrl:0
    v_and_b32_dpp v36, v52, v6 row_shl:4 row_mask:0xf bank_mask:0xf bound_ctrl:0
    v_and_b32_dpp v37, v52, v7 row_shl:4 row_mask:0xf bank_mask:0xf bound_ctrl:0
    v_and_b32 v38, v52, v8
    v_and_b32 v39, v52, v9
    v_mfma_f32_16x16x32_bf16 v[40:43], v[32:35], v[112:115], 0
    v_and_b32 v32, v53, v6
    v_and_b32 v33, v53, v7
    v_and_b32_dpp v34, v53, v8 row_shr:4 row_mask:0xf bank_mask:0xf bound_ctrl:0
    v_and_b32_dpp v35, v53, v9 row_shr:4 row_mask:0xf bank_mask:0xf bound_ctrl:0
    v_mfma_f32_16x16x32_bf16 v[40:43], v[36:39], v[116:119], v[40:43]
    s_nop 0
    v_mfma_f32_16x16x32_bf16 v[40:43], v[32:35], v[120:123], v[40:43]
    s_waitcnt vmcnt(3)
    buffer_load_dwordx4 v[136:139], v3, s[40:43], s35 offen offset:2048 nt
    v_and_b32_dpp v36, v53, v6 row_shl:4 row_mask:0xf bank_mask:0xf bound_ctrl:0
    v_and_b32_dpp v37, v53, v7 row_shl:4 row_mask:0xf bank_mask:0xf bound_ctrl:0
    v_and_b32 v38, v53, v8
    v_and_b32 v39, v53, v9
    s_nop 1
    v_mfma_f32_16x16x32_bf16 v[40:43], v[36:39], v[124:127], v[40:43]
    s_waitcnt vmcnt(3)
    buffer_load_dwordx4 v[140:143], v3, s[40:43], s35 offen offset:3072 nt
    v_and_b32 v32, v54, v6
    v_and_b32 v33, v54, v7
    v_and_b32_dpp v34, v54, v8 row_shr:4 row_mask:0xf bank_mask:0xf bound_ctrl:0
    v_and_b32_dpp v35, v54, v9 row_shr:4 row_mask:0xf bank_mask:0xf bound_ctrl:0
    s_nop 1
    v_mfma_f32_16x16x32_bf16 v[40:43], v[32:35], v[128:131], v[40:43]
    s_waitcnt vmcnt(2)
    s_add_u32 s35, s35, s68
    buffer_load_dwordx4 v[144:147], v3, s[40:43], s35 offen offset:0 nt
    v_and_b32_dpp v36, v54, v6 row_shl:4 row_mask:0xf bank_mask:0xf bound_ctrl:0
    v_and_b32_dpp v37, v54, v7 row_shl:4 row_mask:0xf bank_mask:0xf bound_ctrl:0
    v_and_b32 v38, v54, v8
    v_and_b32 v39, v54, v9
    s_nop 1
    v_mfma_f32_16x16x32_bf16 v[40:43], v[36:39], v[132:135], v[40:43]
    s_waitcnt vmcnt(2)
    buffer_load_dwordx4 v[148:151], v3, s[40:43], s35 offen offset:1024 nt
    v_and_b32 v32, v55, v6
    v_and_b32 v33, v55, v7
    v_and_b32_dpp v34, v55, v8 row_shr:4 row_mask:0xf bank_mask:0xf bound_ctrl:0
    v_and_b32_dpp v35, v55, v9 row_shr:4 row_mask:0xf bank_mask:0xf bound_ctrl:0
    s_nop 1
    v_mfma_f32_16x16x32_bf16 v[40:43], v[32:35], v[136:139], v[40:43]
    s_waitcnt vmcnt(2)
    buffer_load_dwordx4 v[152:155], v3, s[40:43], s35 offen offset:2048 nt
    v_and_b32_dpp v36, v55, v6 row_shl:4 row_mask:0xf bank_mask:0xf bound_ctrl:0
    v_and_b32_dpp v37, v55, v7 row_shl:4 row_mask:0xf bank_mask:0xf bound_ctrl:0
    v_and_b32 v38, v55, v8
    v_and_b32 v39, v55, v9
    s_nop 1
    v_mfma_f32_16x16x32_bf16 v[40:43], v[36:39], v[140:143], v[40:43]
    s_waitcnt vmcnt(2)
    buffer_load_dwordx4 v[156:159], v3, s[40:43], s35 offen offset:3072 nt
    v_and_b32 v32, v56, v6
    v_and_b32 v33, v56, v7
    v_and_b32_dpp v34, v56, v8 row_shr:4 row_mask:0xf bank_mask:0xf bound_ctrl:0
    v_and_b32_dpp v35, v56, v9 row_shr:4 row_mask:0xf bank_mask:0xf bound_ctrl:0
    s_nop 1
    v_mfma_f32_16x16x32_bf16 v[40:43], v[32:35], v[144:147], v[40:43]
    s_waitcnt vmcnt(2)
    s_add_u32 s35, s35, s68
    buffer_load_dwordx4 v[160:163], v3, s[40:43], s35 offen offset:0 nt
    v_and_b32_dpp v36, v56, v6 row_shl:4 row_mask:0xf bank_mask:0xf bound_ctrl:0
    v_and_b32_dpp v37, v56, v7 row_shl:4 row_mask:0xf bank_mask:0xf bound_ctrl:0
    v_and_b32 v38, v56, v8
    v_and_b32 v39, v56, v9
    s_nop 1
    v_mfma_f32_16x16x32_bf16 v[40:43], v[36:39], v[148:151], v[40:43]
    s_waitcnt vmcnt(2)
    buffer_load_dwordx4 v[164:167], v3, s[40:43], s35 offen offset:1024 nt
    v_and_b32 v32, v57, v6
    v_and_b32 v33, v57, v7
    v_and_b32_dpp v34, v57, v8 row_shr:4 row_mask:0xf bank_mask:0xf bound_ctrl:0
    v_and_b32_dpp v35, v57, v9 row_shr:4 row_mask:0xf bank_mask:0xf bound_ctrl:0
    s_nop 1
    v_mfma_f32_16x16x32_bf16 v[40:43], v[32:35], v[152:155], v[40:43]
    s_waitcnt vmcnt(2)
    buffer_load_dwordx4 v[168:171], v3, s[40:43], s35 offen offset:2048 nt
    v_and_b32_dpp v36, v57, v6 row_shl:4 row_mask:0xf bank_mask:0xf bound_ctrl:0
    v_and_b32_dpp v37, v57, v7 row_shl:4 row_mask:0xf bank_mask:0xf bound_ctrl:0
    v_and_b32 v38, v57, v8
    v_and_b32 v39, v57, v9
    s_nop 1
    v_mfma_f32_16x16x32_bf16 v[40:43], v[36:39], v[156:159], v[40:43]
    s_waitcnt vmcnt(2)
    buffer_load_dwordx4 v[172:175], v3, s[40:43], s35 offen offset:3072 nt
    v_and_b32 v32, v58, v6
    v_and_b32 v33, v58, v7
    v_and_b32_dpp v34, v58, v8 row_shr:4 row_mask:0xf bank_mask:0xf bound_ctrl:0
    v_and_b32_dpp v35, v58, v9 row_shr:4 row_mask:0xf bank_mask:0xf bound_ctrl:0
    s_nop 1
    v_mfma_f32_16x16x32_bf16 v[40:43], v[32:35], v[160:163], v[40:43]
    s_waitcnt vmcnt(2)
    s_add_u32 s35, s35, s68
    buffer_load_dwordx4 v[176:179], v3, s[40:43], s35 offen offset:0 nt
    v_and_b32_dpp v36, v58, v6 row_shl:4 row_mask:0xf bank_mask:0xf bound_ctrl:0
    v_and_b32_dpp v37, v58, v7 row_shl:4 row_mask:0xf bank_mask:0xf bound_ctrl:0
    v_and_b32 v38, v58, v8
    v_and_b32 v39, v58, v9
    s_nop 1
    v_mfma_f32_16x16x32_bf16 v[40:43], v[36:39], v[164:167], v[40:43]
    s_waitcnt vmcnt(2)
    buffer_load_dwordx4 v[180:183], v3, s[40:43], s35 offen offset:1024 nt
    v_and_b32 v32, v59, v6
    v_and_b32 v33, v59, v7
    v_and_b32_dpp v34, v59, v8 row_shr:4 row_mask:0xf bank_mask:0xf bound_ctrl:0
    v_and_b32_dpp v35, v59, v9 row_shr:4 row_mask:0xf bank_mask:0xf bound_ctrl:0
    s_nop 1
    v_mfma_f32_16x16x32_bf16 v[40:43], v[32:35], v[168:171], v[40:43]
    s_waitcnt vmcnt(2)
    buffer_load_dwordx4 v[184:187], v3, s[40:43], s35 offen offset:2048 nt
    v_and_b32_dpp v36, v59, v6 row_shl:4 row_mask:0xf bank_mask:0xf bound_ctrl:0
    v_and_b32_dpp v37, v59, v7 row_shl:4 row_mask:0xf bank_mask:0xf bound_ctrl:0
    v_and_b32 v38, v59, v8
    v_and_b32 v39, v59, v9
    s_nop 1
    v_mfma_f32_16x16x32_bf16 v[40:43], v[36:39], v[172:175], v[40:43]
    s_waitcnt vmcnt(2)
    buffer_load_dwordx4 v[188:191], v3, s[40:43], s35 offen offset:3072 nt
    v_and_b32 v32, v60, v6
    v_and_b32 v33, v60, v7
    v_and_b32_dpp v34, v60, v8 row_shr:4 row_mask:0xf bank_mask:0xf bound_ctrl:0
    v_and_b32_dpp v35, v60, v9 row_shr:4 row_mask:0xf bank_mask:0xf bound_ctrl:0
    s_nop 1
    v_mfma_f32_16x16x32_bf16 v[40:43], v[32:35], v[176:179], v[40:43]
    s_waitcnt vmcnt(2)
    s_add_u32 s35, s35, s68
    buffer_load_dwordx4 v[192:195], v3, s[40:43], s35 offen offset:0 nt
    v_and_b32_dpp v36, v60, v6 row_shl:4 row_mask:0xf bank_mask:0xf bound_ctrl:0
    v_and_b32_dpp v37, v60, v7 row_shl:4 row_mask:0xf bank_mask:0xf bound_ctrl:0
    v_and_b32 v38, v60, v8
    v_and_b32 v39, v60, v9
    s_nop 1
    v_mfma_f32_16x16x32_bf16 v[40:43], v[36:39], v[180:183], v[40:43]
    s_cmp_eq_u32 s30, 2
    s_cselect_b64 vcc, -1, 0
    s_cbranch_scc0 ROLE_14
    buffer_load_dwordx3 v[88:90], v3, s[56:59], s78 offen offset:0 sc1
    buffer_load_dwordx3 v[92:94], v3, s[56:59], s78 offen offset:1024 sc1
ROLE_14:
    s_waitcnt vmcnt(4)
    s_cbranch_vccnz RW_15
    s_waitcnt vmcnt(2)
RW_15:
    buffer_load_dwordx4 v[196:199], v3, s[40:43], s35 offen offset:1024 nt
    v_and_b32 v32, v61, v6
    v_and_b32 v33, v61, v7
    v_and_b32_dpp v34, v61, v8 row_shr:4 row_mask:0xf bank_mask:0xf bound_ctrl:0
    v_and_b32_dpp v35, v61, v9 row_shr:4 row_mask:0xf bank_mask:0xf bound_ctrl:0
    s_nop 1
    v_mfma_f32_16x16x32_bf16 v[40:43], v[32:35], v[184:187], v[40:43]
    s_waitcnt vmcnt(4)
    s_cbranch_vccnz RW_16
    s_waitcnt vmcnt(2)
RW_16:
    buffer_load_dwordx4 v[200:203], v3, s[40:43], s35 offen offset:2048 nt
    v_and_b32_dpp v36, v61, v6 row_shl:4 row_mask:0xf bank_mask:0xf bound_ctrl:0
    v_and_b32_dpp v37, v61, v7 row_shl:4 row_mask:0xf bank_mask:0xf bound_ctrl:0
    v_and_b32 v38, v61, v8
    v_and_b32 v39, v61, v9
    s_nop 1
    v_mfma_f32_16x16x32_bf16 v[40:43], v[36:39], v[188:191], v[40:43]
    s_waitcnt vmcnt(4)
    s_cbranch_vccnz RW_17
    s_waitcnt vmcnt(2)
RW_17:
    buffer_load_dwordx4 v[204:207], v3, s[40:43], s35 offen offset:3072 nt
    v_and_b32 v32, v62, v6
    v_and_b32 v33, v62, v7
    v_and_b32_dpp v34, v62, v8 row_shr:4 row_mask:0xf bank_mask:0xf bound_ctrl:0
    v_and_b32_dpp v35, v62, v9 row_shr:4 row_mask:0xf bank_mask:0xf bound_ctrl:0
    s_nop 1
    v_mfma_f32_16x16x32_bf16 v[40:43], v[32:35], v[192:195], v[40:43]
    s_cmp_lg_u32 s30, 2
    s_cbranch_scc1 SKIP_18
    s_waitcnt vmcnt(3)
CHK_19:
    v_cmp_ne_u32 vcc, s60, v90
    v_cmp_ne_u32_e64 s[26:27], s60, v94
    s_or_b64 vcc, vcc, s[26:27]
    s_cbranch_scc0 OK_20
    s_cmp_eq_u32 s69, 0
    s_cbranch_scc1 OK_20
    s_sub_u32 s69, s69, 1
    s_mov_b64 exec, vcc
    buffer_load_dwordx3 v[88:90], v3, s[56:59], s78 offen offset:0 sc1
    buffer_load_dwordx3 v[92:94], v3, s[56:59], s78 offen offset:1024 sc1
    s_mov_b64 exec, -1
    s_waitcnt vmcnt(0)
    s_branch CHK_19
OK_20:
    v_mov_b32 v96, v88
    v_mov_b32 v97, v92
    s_nop 0
    v_max_f32_dpp v96, v96, v96 quad_perm:[1,0,3,2] row_mask:0xf bank_mask:0xf
    v_max_f32_dpp v97, v97, v97 quad_perm:[1,0,3,2] row_mask:0xf bank_mask:0xf
    s_nop 0
    v_max_f32_dpp v96, v96, v96 quad_perm:[2,3,0,1] row_mask:0xf bank_mask:0xf
    v_max_f32_dpp v97, v97, v97 quad_perm:[2,3,0,1] row_mask:0xf bank_mask:0xf
    s_nop 0
    v_max_f32_dpp v96, v96, v96 row_half_mirror row_mask:0xf bank_mask:0xf
    v_max_f32_dpp v97, v97, v97 row_half_mirror row_mask:0xf bank_mask:0xf
    s_nop 0
    v_max_f32_dpp v96, v96, v96 row_ror:8 row_mask:0xf bank_mask:0xf
    v_max_f32_dpp v97, v97, v97 row_ror:8 row_mask:0xf bank_mask:0xf
    v_mov_b32 v72, v96
    v_mov_b32 v73, v97
    s_nop 0
    v_permlane16_swap_b32 v96, v72
    v_permlane16_swap_b32 v97, v73
    v_max_f32 v96, v96, v72
    v_max_f32 v97, v97, v73
    v_mov_b32 v72, v96
    v_mov_b32 v73, v97
    s_nop 0
    v_permlane32_swap_b32 v96, v72
    v_permlane32_swap_b32 v97, v73
    v_max_f32 v96, v96, v72
    v_max_f32 v97, v97, v73
    v_sub_f32 v88, v88, v96
    v_sub_f32 v92, v92, v97
    v_exp_f32 v88, v88
    v_exp_f32 v92, v92
    s_nop 0
    v_mul_f32 v96, v88, v89
    v_mul_f32 v97, v92, v93
    s_nop 0
    v_add_f32_dpp v96, v96, v96 quad_perm:[1,0,3,2] row_mask:0xf bank_mask:0xf
    v_add_f32_dpp v97, v97, v97 quad_perm:[1,0,3,2] row_mask:0xf bank_mask:0xf
    s_nop 0
    v_add_f32_dpp v96, v96, v96 quad_perm:[2,3,0,1] row_mask:0xf bank_mask:0xf
    v_add_f32_dpp v97, v97, v97 quad_perm:[2,3,0,1] row_mask:0xf bank_mask:0xf
    s_nop 0
    v_add_f32_dpp v96, v96, v96 row_half_mirror row_mask:0xf bank_mask:0xf
    v_add_f32_dpp v97, v97, v97 row_half_mirror row_mask:0xf bank_mask:0xf
    s_nop 0
    v_add_f32_dpp v96, v96, v96 row_ror:8 row_mask:0xf bank_mask:0xf
    v_add_f32_dpp v97, v97, v97 row_ror:8 row_mask:0xf bank_mask:0xf
    v_mov_b32 v72, v96
    v_mov_b32 v73, v97
    s_nop 0
    v_permlane16_swap_b32 v96, v72
    v_permlane16_swap_b32 v97, v73
    v_add_f32 v96, v96, v72
    v_add_f32 v97, v97, v73
    v_mov_b32 v72, v96
    v_mov_b32 v73, v97
    s_nop 0
    v_permlane32_swap_b32 v96, v72
    v_permlane32_swap_b32 v97, v73
    v_add_f32 v96, v96, v72
    v_add_f32 v97, v97, v73
    v_rcp_f32 v96, v96
    v_rcp_f32 v97, v97
    s_nop 0
    v_mul_f32 v88, v88, v96
    v_mul_f32 v92, v92, v97
    s_mov_b64 exec, s[90:91]
    ds_write_b32 v23, v88 offset:8704
    ds_write_b32 v23, v92 offset:8736
    s_mov_b64 exec, -1
SKIP_18:
    s_waitcnt vmcnt(2)
    s_add_u32 s35, s35, s68
    buffer_load_dwordx4 v[208:211], v3, s[40:43], s35 offen offset:0 nt
    v_and_b32_dpp v36, v62, v6 row_shl:4 row_mask:0xf bank_mask:0xf bound_ctrl:0
    v_and_b32_dpp v37, v62, v7 row_shl:4 row_mask:0xf bank_mask:0xf bound_ctrl:0
    v_and_b32 v38, v62, v8
    v_and_b32 v39, v62, v9
    s_nop 1
    v_mfma_f32_16x16x32_bf16 v[40:43], v[36:39], v[196:199], v[40:43]
    s_waitcnt vmcnt(2)
    buffer_load_dwordx4 v[212:215], v3, s[40:43], s35 offen offset:1024 nt
    v_and_b32 v32, v63, v6
    v_and_b32 v33, v63, v7
    v_and_b32_dpp v34, v63, v8 row_shr:4 row_mask:0xf bank_mask:0xf bound_ctrl:0
    v_and_b32_dpp v35, v63, v9 row_shr:4 row_mask:0xf bank_mask:0xf bound_ctrl:0
    s_nop 1
    v_mfma_f32_16x16x32_bf16 v[40:43], v[32:35], v[200:203], v[40:43]
    s_waitcnt vmcnt(2)
    buffer_load_dwordx4 v[216:219], v3, s[40:43], s35 offen offset:2048 nt
    v_and_b32_dpp v36, v63, v6 row_shl:4 row_mask:0xf bank_mask:0xf bound_ctrl:0
    v_and_b32_dpp v37, v63, v7 row_shl:4 row_mask:0xf bank_mask:0xf bound_ctrl:0
    v_and_b32 v38, v63, v8
    v_and_b32 v39, v63, v9
    s_nop 1
    v_mfma_f32_16x16x32_bf16 v[40:43], v[36:39], v[204:207], v[40:43]
    s_waitcnt vmcnt(2)
    buffer_load_dwordx4 v[220:223], v3, s[40:43], s35 offen offset:3072 nt
    v_and_b32 v32, v64, v6
    v_and_b32 v33, v64, v7
    v_and_b32_dpp v34, v64, v8 row_shr:4 row_mask:0xf bank_mask:0xf bound_ctrl:0
    v_and_b32_dpp v35, v64, v9 row_shr:4 row_mask:0xf bank_mask:0xf bound_ctrl:0
    s_nop 1
    v_mfma_f32_16x16x32_bf16 v[40:43], v[32:35], v[208:211], v[40:43]
    s_waitcnt vmcnt(2)
    s_add_u32 s35, s35, s68
    buffer_load_dwordx4 v[224:227], v3, s[40:43], s35 offen offset:0 nt
    v_and_b32_dpp v36, v64, v6 row_shl:4 row_mask:0xf bank_mask:0xf bound_ctrl:0
    v_and_b32_dpp v37, v64, v7 row_shl:4 row_mask:0xf bank_mask:0xf bound_ctrl:0
    v_and_b32 v38, v64, v8
    v_and_b32 v39, v64, v9
    s_nop 1
    v_mfma_f32_16x16x32_bf16 v[40:43], v[36:39], v[212:215], v[40:43]
    s_waitcnt vmcnt(2)
    buffer_load_dwordx4 v[228:231], v3, s[40:43], s35 offen offset:1024 nt
    v_and_b32 v32, v65, v6
    v_and_b32 v33, v65, v7
    v_and_b32_dpp v34, v65, v8 row_shr:4 row_mask:0xf bank_mask:0xf bound_ctrl:0
    v_and_b32_dpp v35, v65, v9 row_shr:4 row_mask:0xf bank_mask:0xf bound_ctrl:0
    s_nop 1
    v_mfma_f32_16x16x32_bf16 v[40:43], v[32:35], v[216:219], v[40:43]
    s_waitcnt vmcnt(2)
    buffer_load_dwordx4 v[232:235], v3, s[40:43], s35 offen offset:2048 nt
    v_and_b32_dpp v36, v65, v6 row_shl:4 row_mask:0xf bank_mask:0xf bound_ctrl:0
    v_and_b32_dpp v37, v65, v7 row_shl:4 row_mask:0xf bank_mask:0xf bound_ctrl:0
    v_and_b32 v38, v65, v8
    v_and_b32 v39, v65, v9
    s_nop 1
    v_mfma_f32_16x16x32_bf16 v[40:43], v[36:39], v[220:223], v[40:43]
    s_waitcnt vmcnt(2)
    buffer_load_dwordx4 v[236:239], v3, s[40:43], s35 offen offset:3072 nt
    v_and_b32 v32, v66, v6
    v_and_b32 v33, v66, v7
    v_and_b32_dpp v34, v66, v8 row_shr:4 row_mask:0xf bank_mask:0xf bound_ctrl:0
    v_and_b32_dpp v35, v66, v9 row_shr:4 row_mask:0xf bank_mask:0xf bound_ctrl:0
    s_nop 1
    v_mfma_f32_16x16x32_bf16 v[40:43], v[32:35], v[224:227], v[40:43]
    s_waitcnt vmcnt(2)
    buffer_load_dwordx4 v[112:115], v19, s[52:55], 0 offen offset:0 nt
    v_and_b32_dpp v36, v66, v6 row_shl:4 row_mask:0xf bank_mask:0xf bound_ctrl:0
    v_and_b32_dpp v37, v66, v7 row_shl:4 row_mask:0xf bank_mask:0xf bound_ctrl:0
    v_and_b32 v38, v66, v8
    v_and_b32 v39, v66, v9
    s_nop 1
    v_mfma_f32_16x16x32_bf16 v[40:43], v[36:39], v[228:231], v[40:43]
    s_waitcnt vmcnt(2)
    buffer_load_dwordx4 v[116:119], v19, s[52:55], 0 offen offset:1152 nt
    v_and_b32 v32, v67, v6
    v_and_b32 v33, v67, v7
    v_and_b32_dpp v34, v67, v8 row_shr:4 row_mask:0xf bank_mask:0xf bound_ctrl:0
    v_and_b32_dpp v35, v67, v9 row_shr:4 row_mask:0xf bank_mask:0xf bound_ctrl:0
    s_nop 1
    v_mfma_f32_16x16x32_bf16 v[40:43], v[32:35], v[232:235], v[40:43]
    s_waitcnt vmcnt(2)
    buffer_load_dwordx4 v[120:123], v19, s[52:55], 0 offen offset:2304 nt
    v_and_b32_dpp v36, v67, v6 row_shl:4 row_mask:0xf bank_mask:0xf bound_ctrl:0
    v_and_b32_dpp v37, v67, v7 row_shl:4 row_mask:0xf bank_mask:0xf bound_ctrl:0
    v_and_b32 v38, v67, v8
    v_and_b32 v39, v67, v9
    s_nop 1
    v_mfma_f32_16x16x32_bf16 v[40:43], v[36:39], v[236:239], v[40:43]
    buffer_load_dwordx4 v[124:127], v19, s[52:55], 0 offen offset:3456 nt
    buffer_load_dwordx4 v[128:131], v20, s[52:55], 0 offen offset:0 nt
    buffer_load_dwordx4 v[132:135], v20, s[52:55], 0 offen offset:1152 nt
    buffer_load_dwordx4 v[136:139], v20, s[52:55], 0 offen offset:2304 nt
    buffer_load_dwordx4 v[140:143], v20, s[52:55], 0 offen offset:3456 nt
    s_nop 2
    ds_write_b128 v14, v[40:43] offset:9216
    s_waitcnt lgkmcnt(0)
    s_barrier
    ds_read_b128 v[72:75], v15 offset:9216
    ds_read_b32 v76, v16 offset:8704
    s_waitcnt lgkmcnt(0)
    v_mul_f32 v72, v72, v76
    v_mul_f32 v73, v73, v76
    v_mul_f32 v74, v74, v76
    v_mul_f32 v75, v75, v76
    v_add_f32_dpp v72, v72, v72 quad_perm:[1,0,3,2] row_mask:0xf bank_mask:0xf
    v_add_f32_dpp v73, v73, v73 quad_perm:[1,0,3,2] row_mask:0xf bank_mask:0xf
    v_add_f32_dpp v74, v74, v74 quad_perm:[1,0,3,2] row_mask:0xf bank_mask:0xf
    v_add_f32_dpp v75, v75, v75 quad_perm:[1,0,3,2] row_mask:0xf bank_mask:0xf
    v_add_f32_dpp v72, v72, v72 quad_perm:[2,3,0,1] row_mask:0xf bank_mask:0xf
    v_add_f32_dpp v73, v73, v73 quad_perm:[2,3,0,1] row_mask:0xf bank_mask:0xf
    v_add_f32_dpp v74, v74, v74 quad_perm:[2,3,0,1] row_mask:0xf bank_mask:0xf
    v_add_f32_dpp v75, v75, v75 quad_perm:[2,3,0,1] row_mask:0xf bank_mask:0xf
    v_add_f32_dpp v72, v72, v72 row_half_mirror row_mask:0xf bank_mask:0xf
    v_add_f32_dpp v73, v73, v73 row_half_mirror row_mask:0xf bank_mask:0xf
    v_add_f32_dpp v74, v74, v74 row_half_mirror row_mask:0xf bank_mask:0xf
    v_add_f32_dpp v75, v75, v75 row_half_mirror row_mask:0xf bank_mask:0xf
    v_perm_b32 v72, v72, v75, s62
    v_perm_b32 v73, v73, v75, s63
    v_perm_b32 v74, v74, v75, s98
    v_mov_b32 v75, s60
    s_mov_b64 exec, s[84:85]
    s_cmp_eq_u32 s22, 0
    s_cbranch_scc1 FAR_21
    buffer_store_dwordx4 v[72:75], v17, s[56:59], s79 offen
    s_branch STD_22
FAR_21:
    buffer_store_dwordx4 v[72:75], v17, s[56:59], s79 offen sc1
STD_22:
    s_mov_b64 exec, -1
    buffer_load_dwordx4 v[80:83], v18, s[56:59], s80 offen sc1
    v_mov_b32 v176, 0
    v_mov_b32 v177, 0
    v_mov_b32 v178, 0
    v_mov_b32 v179, 0
    s_waitcnt vmcnt(0)
CHK_23:
    v_cmp_ne_u32 vcc, s60, v83
    s_cbranch_vccz OK_24
    s_cmp_eq_u32 s69, 0
    s_cbranch_scc1 OK_24
    s_sub_u32 s69, s69, 1
    s_mov_b64 exec, vcc
    buffer_load_dwordx4 v[80:83], v18, s[56:59], s80 offen sc1
    s_mov_b64 exec, -1
    s_waitcnt vmcnt(0)
    s_branch CHK_23
OK_24:
    v_perm_b32 v83, v81, v80, s99
    v_perm_b32 v83, v82, v83, s100
    v_add_f32_dpp v80, v80, v80 quad_perm:[1,0,3,2] row_mask:0xf bank_mask:0xf
    v_add_f32_dpp v81, v81, v81 quad_perm:[1,0,3,2] row_mask:0xf bank_mask:0xf
    v_add_f32_dpp v82, v82, v82 quad_perm:[1,0,3,2] row_mask:0xf bank_mask:0xf
    v_add_f32_dpp v83, v83, v83 quad_perm:[1,0,3,2] row_mask:0xf bank_mask:0xf
    v_add_f32_dpp v80, v80, v80 quad_perm:[2,3,0,1] row_mask:0xf bank_mask:0xf
    v_add_f32_dpp v81, v81, v81 quad_perm:[2,3,0,1] row_mask:0xf bank_mask:0xf
    v_add_f32_dpp v82, v82, v82 quad_perm:[2,3,0,1] row_mask:0xf bank_mask:0xf
    v_add_f32_dpp v83, v83, v83 quad_perm:[2,3,0,1] row_mask:0xf bank_mask:0xf
    v_add_f32_dpp v80, v80, v80 row_half_mirror row_mask:0xf bank_mask:0xf
    v_add_f32_dpp v81, v81, v81 row_half_mirror row_mask:0xf bank_mask:0xf
    v_add_f32_dpp v82, v82, v82 row_half_mirror row_mask:0xf bank_mask:0xf
    v_add_f32_dpp v83, v83, v83 row_half_mirror row_mask:0xf bank_mask:0xf
    v_cvt_pk_bf16_f32 v80, v80, v80
    v_cvt_pk_bf16_f32 v81, v81, v81
    v_cvt_pk_bf16_f32 v82, v82, v82
    v_cvt_pk_bf16_f32 v83, v83, v83
    v_and_b32 v32, v80, v6
    v_and_b32 v33, v80, v7
    v_and_b32 v34, v80, v8
    v_and_b32 v35, v80, v9
    v_and_b32 v36, v81, v6
    v_and_b32 v37, v81, v7
    v_and_b32 v38, v81, v8
    v_and_b32 v39, v81, v9
    v_mfma_f32_16x16x32_bf16 v[44:47], v[32:35], v[112:115], 0
    v_mfma_f32_16x16x32_bf16 v[48:51], v[32:35], v[128:131], 0
    v_and_b32 v32, v82, v6
    v_and_b32 v33, v82, v7
    v_and_b32 v34, v82, v8
    v_and_b32 v35, v82, v9
    v_mfma_f32_16x16x32_bf16 v[44:47], v[36:39], v[116:119], v[44:47]
    v_mfma_f32_16x16x32_bf16 v[48:51], v[36:39], v[132:135], v[48:51]
    v_and_b32 v36, v83, v6
    v_and_b32 v37, v83, v7
    v_and_b32 v38, v83, v8
    v_and_b32 v39, v83, v9
    v_mfma_f32_16x16x32_bf16 v[44:47], v[32:35], v[120:123], v[44:47]
    v_mfma_f32_16x16x32_bf16 v[48:51], v[32:35], v[136:139], v[48:51]
    v_mfma_f32_16x16x32_bf16 v[44:47], v[36:39], v[124:127], v[44:47]
    v_mfma_f32_16x16x32_bf16 v[48:51], v[36:39], v[140:143], v[48:51]
    s_nop 7
    v_permlane32_swap_b32 v44, v48
    v_permlane32_swap_b32 v45, v49
    v_permlane32_swap_b32 v46, v50
    v_permlane32_swap_b32 v47, v51
    v_add_f32_dpp v44, v48, v44 row_ror:8 row_mask:0xf bank_mask:0xf
    v_add_f32_dpp v45, v49, v45 row_ror:8 row_mask:0xf bank_mask:0xf
    v_add_f32_dpp v46, v50, v46 row_ror:8 row_mask:0xf bank_mask:0xf
    v_add_f32_dpp v47, v51, v47 row_ror:8 row_mask:0xf bank_mask:0xf
    s_mov_b64 exec, s[86:87]
    ds_write_b128 v4, v[44:47]
    s_mov_b64 exec, -1
    s_waitcnt lgkmcnt(0)
    s_barrier
    s_cmp_lg_u32 s30, 0
    s_cbranch_scc1 SKIP_25
    ds_read_b128 v[144:147], v13 offset:0
    ds_read_b128 v[148:151], v13 offset:256
    ds_read_b128 v[152:155], v13 offset:512
    ds_read_b128 v[156:159], v13 offset:768
    ds_read_b128 v[160:163], v13 offset:1024
    ds_read_b128 v[164:167], v13 offset:1280
    ds_read_b128 v[168:171], v13 offset:1536
    ds_read_b128 v[172:175], v13 offset:1792
    s_waitcnt lgkmcnt(6)
    v_pk_add_f32 v[144:145], v[144:145], v[148:149]
    v_pk_add_f32 v[146:147], v[146:147], v[150:151]
    s_waitcnt lgkmcnt(5)
    v_pk_add_f32 v[144:145], v[144:145], v[152:153]
    v_pk_add_f32 v[146:147], v[146:147], v[154:155]
    s_waitcnt lgkmcnt(4)
    v_pk_add_f32 v[144:145], v[144:145], v[156:157]
    v_pk_add_f32 v[146:147], v[146:147], v[158:159]
    s_waitcnt lgkmcnt(3)
    v_pk_add_f32 v[144:145], v[144:145], v[160:161]
    v_pk_add_f32 v[146:147], v[146:147], v[162:163]
    s_waitcnt lgkmcnt(2)
    v_pk_add_f32 v[144:145], v[144:145], v[164:165]
    v_pk_add_f32 v[146:147], v[146:147], v[166:167]
    s_waitcnt lgkmcnt(1)
    v_pk_add_f32 v[144:145], v[144:145], v[168:169]
    v_pk_add_f32 v[146:147], v[146:147], v[170:171]
    s_waitcnt lgkmcnt(0)
    v_pk_add_f32 v[144:145], v[144:145], v[172:173]
    v_pk_add_f32 v[146:147], v[146:147], v[174:175]
    v_perm_b32 v144, v144, v147, s62
    v_perm_b32 v145, v145, v147, s63
    v_perm_b32 v146, v146, v147, s98
    v_mov_b32 v147, s60
    v_bitop3_b32 v147, v147, v144, v145 bitop3:0x96
    v_xor_b32 v147, v147, v146
    s_mov_b32 exec_lo, 0
    v_mov_b32 v144, v146
    v_mov_b32 v145, v147
    s_mov_b32 exec_lo, -1
    buffer_atomic_swap_x2 v[144:145], v21, s[56:59], s81 offen sc1
    s_mov_b64 exec, -1
SKIP_25:
    s_cmp_lg_u32 s30, 0
    s_cbranch_scc1 L_fin
    s_cmp_ge_u32 s101, 72
    s_cbranch_scc1 L_fin
    s_mov_b64 exec, s[24:25]
    v_mov_b32 v176, 0
    v_mov_b32 v177, 0
    v_mov_b32 v178, 0
    v_mov_b32 v179, 0
    buffer_atomic_add_x2 v[178:179], v3, s[56:59], s82 offen offset:8 sc0 sc1
    buffer_atomic_add_x2 v[176:177], v3, s[56:59], s82 offen sc0 sc1
    s_waitcnt vmcnt(0)
CHK_26:
    v_bitop3_b32 v76, v179, v176, v177 bitop3:0x96
    v_xor_b32 v76, v76, v178
    v_cmp_ne_u32 vcc, s60, v76
    s_cbranch_vccz OK_27
    s_cmp_eq_u32 s69, 0
    s_cbranch_scc1 OK_27
    s_sub_u32 s69, s69, 1
    s_mov_b64 exec, vcc
    v_mov_b32 v176, 0
    v_mov_b32 v177, 0
    v_mov_b32 v178, 0
    v_mov_b32 v179, 0
    buffer_atomic_add_x2 v[178:179], v3, s[56:59], s82 offen offset:8 sc0 sc1
    buffer_atomic_add_x2 v[176:177], v3, s[56:59], s82 offen sc0 sc1
    s_mov_b64 exec, s[24:25]
    s_waitcnt vmcnt(0)
    s_branch CHK_26
OK_27:
    s_mov_b64 exec, -1
    v_perm_b32 v179, v177, v176, s99
    v_perm_b32 v179, v178, v179, s100
    v_permlane32_swap_b32 v176, v178
    s_nop 0
    v_permlane32_swap_b32 v177, v179
    v_add_f32 v176, v176, v178
    v_add_f32 v177, v177, v179
    s_nop 1
    v_permlane16_swap_b32 v176, v177
    v_add_f32 v176, v176, v177
    s_nop 1
    v_add_f32_dpp v176, v176, v176 row_ror:8 row_mask:0xf bank_mask:0xf
    s_nop 1
    v_add_f32_dpp v176, v176, v176 row_ror:4 row_mask:0xf bank_mask:0xf
    s_nop 1
    v_add_f32_dpp v176, v176, v176 quad_perm:[2,3,0,1] row_mask:0xf bank_mask:0xf
    v_cvt_pk_bf16_f32 v176, v176, v176
    s_mov_b64 exec, s[88:89]
    buffer_store_short v176, v22, s[64:67], s83 offen
    s_cmp_lg_u32 s101, 0
    s_cbranch_scc1 L_fin2
    v_mov_b32 v72, s60
    s_mov_b64 exec, 1
    buffer_store_dword v72, off, s[56:59], s61
L_fin2:
    s_mov_b64 exec, -1
L_fin:
L_end:
    s_endpgm

.section .rodata,"a"
.p2align 6
.amdhsa_kernel concat_heads__gqa_block_cached__gqa_block_cached__decode_kernel
  .amdhsa_next_free_vgpr 244
  .amdhsa_next_free_sgpr 102
  .amdhsa_accum_offset 244
  .amdhsa_group_segment_fixed_size 0
  .amdhsa_kernarg_size 104
  .amdhsa_user_sgpr_count 2
  .amdhsa_user_sgpr_kernarg_segment_ptr 1
  .amdhsa_system_sgpr_workgroup_id_x 1
  .amdhsa_float_denorm_mode_32 3
.end_amdhsa_kernel
```
